```python
import torch

def _softmax(x, axis=-1):
    return torch.softmax(x, dim=axis)
def _gelu(x):
    return torch.nn.functional.gelu(x, approximate="tanh")
def _silu(x):
    return torch.nn.functional.silu(x)
def _sigmoid(x):
    return torch.sigmoid(x)
def _layernorm(x, axis=-1, eps=1e-5):
    m = x.mean(dim=axis, keepdim=True)
    v = x.var(dim=axis, keepdim=True, unbiased=False)
    return (x - m) / torch.sqrt(v + eps)
def _scatter_add(tgt, idx, src, axis=0):
    return tgt.clone().index_add_(axis, idx, src)
def _segment_sum(src, seg, n):
    out = torch.zeros((n,) + src.shape[1:], dtype=src.dtype)
    return out.index_add_(0, seg, src)
def _pad(x, pw):
    flat = tuple(v for pair in reversed(pw) for v in pair)
    return torch.nn.functional.pad(x, flat)

kernel_name = 'concat_heads__sliding_block_cached__sliding_block_cached__decode'

def setup_inputs():

    _w = (lambda a: (lambda t: t.to(torch.bfloat16) if t.is_floating_point() else t)(torch.as_tensor(a)))
    def _A_setup():
        B, Sq, D = 2, 1, 576
        Hq, Hkv, Sk, Dh = 32, 16, 16384, 128
        assert Hq % Hkv == 0, (Hq, Hkv)
        return {
            "x": _w((lambda *s: torch.randn(*s, dtype=torch.bfloat16) * 0.8)(B, Sq, D)),
            "k_cache": _w((lambda *s: torch.randn(*s, dtype=torch.bfloat16) * 0.8)(B, Hkv, Sk, Dh)),
            "v_cache": _w((lambda *s: torch.randn(*s, dtype=torch.bfloat16) * 0.05)(B, Hkv, Sk, Dh)),
            "wq": _w((lambda *s: torch.randn(*s, dtype=torch.bfloat16) * 0.8)(D, Hq * Dh) * (D ** -0.5)),
            "wo": _w((lambda *s: torch.randn(*s, dtype=torch.bfloat16) * 0.05)(Hq * Dh, D) * ((Hq * Dh) ** -0.5)),
        }
    _A_in = _A_setup()

    def _B_setup():
        B, Sq, D = 2, 1, 576
        Hq, Hkv, Sk, Dh = 32, 16, 16384, 128
        assert Hq % Hkv == 0, (Hq, Hkv)
        return {
            "x": _w((lambda *s: torch.randn(*s, dtype=torch.bfloat16) * 0.8)(B, Sq, D)),
            "k_cache": _w((lambda *s: torch.randn(*s, dtype=torch.bfloat16) * 0.8)(B, Hkv, Sk, Dh)),
            "v_cache": _w((lambda *s: torch.randn(*s, dtype=torch.bfloat16) * 0.05)(B, Hkv, Sk, Dh)),
            "wq": _w((lambda *s: torch.randn(*s, dtype=torch.bfloat16) * 0.8)(D, Hq * Dh) * (D ** -0.5)),
            "wo": _w((lambda *s: torch.randn(*s, dtype=torch.bfloat16) * 0.05)(Hq * Dh, D) * ((Hq * Dh) ** -0.5)),
        }
    _B_in = _B_setup()

    return {
        "A_x": _A_in["x"],
        "A_k_cache": _A_in["k_cache"],
        "A_v_cache": _A_in["v_cache"],
        "A_wq": _A_in["wq"],
        "A_wo": _A_in["wo"],
        "B_x": _B_in["x"],
        "B_k_cache": _B_in["k_cache"],
        "B_v_cache": _B_in["v_cache"],
        "B_wq": _B_in["wq"],
        "B_wo": _B_in["wo"],
    }

def reference(A_x, A_k_cache, A_v_cache, A_wq, A_wo, B_x, B_k_cache, B_v_cache, B_wq, B_wo):
    def _A_ref(x, k_cache, v_cache, wq, wo):
        B, Sq, D = x.shape
        Hq, Dh = 32, 128
        Hkv, Sk = k_cache.shape[1], k_cache.shape[2]
        W = min(4096, max(256, Sk // 4))
        rep = Hq // Hkv
        q = (lambda x, *d: x.permute(*d))((x @ wq).reshape(B, Sq, Hq, Dh), 0, 2, 1, 3)
        k = (lambda x, n, axis: torch.repeat_interleave(x, n, dim=axis))(k_cache[:, :, Sk - W:, :], rep, axis=1)
        v = (lambda x, n, axis: torch.repeat_interleave(x, n, dim=axis))(v_cache[:, :, Sk - W:, :], rep, axis=1)
        scores = torch.einsum("bhqd,bhkd->bhqk", q, k) * (Dh ** -0.5)
        p = _softmax(scores, axis=-1)
        o = torch.einsum("bhqk,bhkd->bhqd", p, v)
        return (lambda x, *d: x.permute(*d))(o, 0, 2, 1, 3).reshape(B, Sq, Hq * Dh) @ wo

    def _B_ref(x, k_cache, v_cache, wq, wo):
        B, Sq, D = x.shape
        Hq, Dh = 32, 128
        Hkv, Sk = k_cache.shape[1], k_cache.shape[2]
        W = min(4096, max(256, Sk // 4))
        rep = Hq // Hkv
        q = (lambda x, *d: x.permute(*d))((x @ wq).reshape(B, Sq, Hq, Dh), 0, 2, 1, 3)
        k = (lambda x, n, axis: torch.repeat_interleave(x, n, dim=axis))(k_cache[:, :, Sk - W:, :], rep, axis=1)
        v = (lambda x, n, axis: torch.repeat_interleave(x, n, dim=axis))(v_cache[:, :, Sk - W:, :], rep, axis=1)
        scores = torch.einsum("bhqd,bhkd->bhqk", q, k) * (Dh ** -0.5)
        p = _softmax(scores, axis=-1)
        o = torch.einsum("bhqk,bhkd->bhqd", p, v)
        return (lambda x, *d: x.permute(*d))(o, 0, 2, 1, 3).reshape(B, Sq, Hq * Dh) @ wo

    a = _A_ref(A_x, A_k_cache, A_v_cache, A_wq, A_wo)
    b = _B_ref(B_x, B_k_cache, B_v_cache, B_wq, B_wo)
    return torch.concatenate([a, b], axis=-1)
```

```asm
; @launch grid=(256,1,1) block=(256,1,1) lds=11776
.amdgcn_target "amdgcn-amd-amdhsa--gfx950"
.text
.globl concat_heads__sliding_block_cached__sliding_block_cached__decode_kernel
.p2align 8
.type concat_heads__sliding_block_cached__sliding_block_cached__decode_kernel,@function
concat_heads__sliding_block_cached__sliding_block_cached__decode_kernel:
s_cmp_ge_u32 s2, 256
s_cbranch_scc1 L_end
s_and_b32 s3, s2, 7
s_lshr_b32 s4, s2, 3
s_and_b32 s5, s4, 3
s_lshl_b32 s3, s3, 2
s_add_u32 s3, s3, s5
s_lshr_b32 s4, s2, 5
s_lshr_b32 s5, s2, 1
s_xor_b32 s6, s5, s2
s_and_b32 s6, s6, 1
s_lshr_b32 s4, s2, 4
s_lshl_b32 s3, s4, 1
s_add_u32 s3, s3, s6
s_add_u32 s5, s5, s4
s_and_b32 s5, s5, 3
s_bfe_u32 s6, s2, 0x10003
s_lshl_b32 s4, s6, 2
s_add_u32 s4, s4, s5
s_lshl_b32 s7, s5, 1
s_add_u32 s7, s7, s6
s_lshr_b32 s5, s3, 4
s_and_b32 s6, s3, 15
s_load_dwordx2 s[18:19], s[0:1], 80
s_load_dwordx2 s[64:65], s[0:1], 96
s_mul_i32 s70, s5, 40
s_add_u32 s0, s0, s70
s_addc_u32 s1, s1, 0
s_load_dwordx4 s[8:11], s[0:1], 0
s_load_dwordx4 s[12:15], s[0:1], 16
s_load_dwordx2 s[16:17], s[0:1], 32
v_lshrrev_b32 v1, 6, v0
v_and_b32 v0, 63, v0
v_readfirstlane_b32 s20, v1
s_lshr_b32 s21, s4, 2
s_and_b32 s22, s4, 3
v_and_b32 v1, 15, v0
v_lshrrev_b32 v2, 4, v0
s_mul_i32 s70, s21, 288
s_mul_i32 s71, s20, 72
s_add_u32 s70, s70, s71
v_lshrrev_b32 v9, 3, v1
v_lshl_add_u32 v9, v9, 2, v2
v_and_b32 v10, 7, v1
v_lshlrev_b32 v10, 4, v10
v_lshl_add_u32 v5, v9, 16, v10
v_add_u32 v9, 64, v9
v_lshl_add_u32 v6, v9, 13, v10
v_bfe_u32 v9, v1, 1, 1
v_lshl_add_u32 v9, v9, 2, v2
v_and_b32 v10, 1, v1
v_mul_u32_u24 v10, 1152, v10
s_lshl_b32 s71, s70, 1
v_add_u32 v10, s71, v10
v_lshl_add_u32 v7, v9, 4, v10
v_lshl_add_u32 v8, v9, 1, v10
v_add_u32 v8, 128, v8
v_lshlrev_b32 v3, 8, v1
v_lshl_add_u32 v3, v2, 4, v3
v_lshlrev_b32 v4, 10, v2
v_lshl_add_u32 v4, v1, 4, v4
s_lshl_b32 s72, s70, 13
s_lshl_b32 s73, s6, 9
s_add_u32 s72, s72, s73
s_lshl_b32 s73, s22, 7
s_add_u32 s72, s72, s73
s_lshl_b32 s73, s21, 4
s_add_u32 s73, s73, s6
s_lshl_b32 s73, s73, 22
s_add_u32 s73, s73, 12288*256
s_lshl_b32 s74, s22, 2
s_add_u32 s74, s74, s20
s_lshl_b32 s74, s74, 12
s_waitcnt lgkmcnt(0)
s_mov_b32 s36, s8
s_mov_b32 s37, s9
s_mov_b32 s38, 2304
s_mov_b32 s39, 0x20000
s_add_u32 s32, s14, s72
s_addc_u32 s33, s15, 0
s_sub_u32 s34, 4718592, s72
s_mov_b32 s35, 0x20000
s_mov_b32 s40, s64
s_mov_b32 s41, s65
s_mov_b32 s42, 1179648
s_mov_b32 s43, 0x20000
v_mov_b32 v30, 0
s_lshl_b32 s57, s3, 1
s_add_u32 s57, s57, s21
s_lshl_b32 s57, s57, 8
s_add_u32 s57, s57, 1118208
s_or_b32 s70, s20, s22
s_cmp_lg_u32 s70, 0
s_cbranch_scc1 L_noinit
s_mov_b64 exec, 1
buffer_store_dword v30, v30, s[40:43], s57 offen sc1
s_mov_b64 exec, -1
L_noinit:
buffer_load_dwordx4 v[196:199], v7, s[36:39], 0 offen
buffer_load_ushort v200, v8, s[36:39], 0 offen
s_mov_b32 s69, 0
buffer_load_dwordx4 v[128:131], v5, s[32:35], s69 offen nt
s_mov_b32 s69, 8192
buffer_load_dwordx4 v[132:135], v5, s[32:35], s69 offen nt
s_mov_b32 s69, 16384
buffer_load_dwordx4 v[136:139], v5, s[32:35], s69 offen nt
s_mov_b32 s69, 24576
buffer_load_dwordx4 v[140:143], v5, s[32:35], s69 offen nt
s_mov_b32 s69, 32768
buffer_load_dwordx4 v[144:147], v5, s[32:35], s69 offen nt
s_mov_b32 s69, 40960
buffer_load_dwordx4 v[148:151], v5, s[32:35], s69 offen nt
s_mov_b32 s69, 49152
buffer_load_dwordx4 v[152:155], v5, s[32:35], s69 offen nt
s_mov_b32 s69, 57344
buffer_load_dwordx4 v[156:159], v5, s[32:35], s69 offen nt
buffer_load_dwordx4 v[160:163], v6, s[32:35], 0 offen nt
v_mov_b32 v31, 0
ds_write_b64 v30, v[30:31] offset:4864
v_mov_b32 v31, 1
s_waitcnt lgkmcnt(0)
s_barrier
s_add_u32 s24, s10, s73
s_addc_u32 s25, s11, 0
s_mov_b32 s26, 1048576
s_mov_b32 s27, 0x20000
s_add_u32 s28, s12, s73
s_addc_u32 s29, s13, 0
s_mov_b32 s30, 1048576
s_mov_b32 s31, 0x20000
s_lshl_b32 s15, s3, 1
s_add_u32 s15, s15, s21
s_mul_i32 s15, s15, 0
s_add_u32 s74, s74, s15
s_add_u32 s15, s15, 0x80000
s_add_u32 s48, s74, 0
s_and_b32 s48, s48, 0xfffff
s_add_u32 s49, s74, 65536
s_and_b32 s49, s49, 0xfffff
s_add_u32 s50, s74, 131072
s_and_b32 s50, s50, 0xfffff
s_add_u32 s51, s74, 196608
s_and_b32 s51, s51, 0xfffff
s_add_u32 s52, s74, 262144
s_and_b32 s52, s52, 0xfffff
s_add_u32 s53, s74, 327680
s_and_b32 s53, s53, 0xfffff
s_add_u32 s54, s74, 393216
s_and_b32 s54, s54, 0xfffff
s_add_u32 s55, s74, 458752
s_and_b32 s55, s55, 0xfffff
s_lshl_b32 s75, s5, 8
s_add_u32 s75, s75, 1114112
s_add_u32 s76, s64, s75
s_addc_u32 s77, s65, 0
s_load_dword s23, s[76:77], 0
s_mov_b32 s44, s18
s_mov_b32 s45, s19
s_mov_b32 s46, 4608
s_mov_b32 s47, 0x20000
s_mov_b32 s66, 0x05040100
s_mov_b32 s67, 0x07060302
s_mov_b32 s68, 0x3e0293ee
buffer_load_dwordx4 a[0:3], v3, s[24:27], s48 offen offset:0 nt
buffer_load_dwordx4 a[4:7], v3, s[24:27], s48 offen offset:64 nt
buffer_load_dwordx4 a[8:11], v3, s[24:27], s48 offen offset:128 nt
buffer_load_dwordx4 a[12:15], v3, s[24:27], s48 offen offset:192 nt
buffer_load_dwordx4 a[16:19], v3, s[24:27], s49 offen offset:0 nt
buffer_load_dwordx4 a[20:23], v3, s[24:27], s49 offen offset:64 nt
buffer_load_dwordx4 a[24:27], v3, s[24:27], s49 offen offset:128 nt
buffer_load_dwordx4 a[28:31], v3, s[24:27], s49 offen offset:192 nt
buffer_load_dwordx4 a[32:35], v3, s[24:27], s50 offen offset:0 nt
buffer_load_dwordx4 a[36:39], v3, s[24:27], s50 offen offset:64 nt
s_waitcnt vmcnt(10)
v_mov_b32 v201, 0
v_lshlrev_b32 v202, 16, v200
v_mov_b32 v203, 0
v_mov_b32 v204, 0
v_mov_b32 v205, v200
v_mov_b32 v206, 0
v_lshlrev_b32 v207, 16, v200
v_perm_b32 v48, v132, v128, s66
v_perm_b32 v49, v140, v136, s66
v_perm_b32 v50, v148, v144, s66
v_perm_b32 v51, v156, v152, s66
v_perm_b32 v52, v132, v128, s67
v_perm_b32 v53, v140, v136, s67
v_perm_b32 v54, v148, v144, s67
v_perm_b32 v55, v156, v152, s67
v_perm_b32 v56, v133, v129, s66
v_perm_b32 v57, v141, v137, s66
v_perm_b32 v58, v149, v145, s66
v_perm_b32 v59, v157, v153, s66
v_perm_b32 v60, v133, v129, s67
v_perm_b32 v61, v141, v137, s67
v_perm_b32 v62, v149, v145, s67
v_perm_b32 v63, v157, v153, s67
v_mfma_f32_16x16x32_bf16 v[164:167], v[196:199], v[48:51], 0
v_mfma_f32_16x16x32_bf16 v[168:171], v[196:199], v[52:55], 0
v_perm_b32 v48, v134, v130, s66
v_perm_b32 v49, v142, v138, s66
v_perm_b32 v50, v150, v146, s66
v_perm_b32 v51, v158, v154, s66
v_perm_b32 v52, v134, v130, s67
v_perm_b32 v53, v142, v138, s67
v_perm_b32 v54, v150, v146, s67
v_perm_b32 v55, v158, v154, s67
v_mfma_f32_16x16x32_bf16 v[172:175], v[196:199], v[56:59], 0
v_mfma_f32_16x16x32_bf16 v[176:179], v[196:199], v[60:63], 0
v_perm_b32 v56, v135, v131, s66
v_perm_b32 v57, v143, v139, s66
v_perm_b32 v58, v151, v147, s66
v_perm_b32 v59, v159, v155, s66
v_perm_b32 v60, v135, v131, s67
v_perm_b32 v61, v143, v139, s67
v_perm_b32 v62, v151, v147, s67
v_perm_b32 v63, v159, v155, s67
v_mfma_f32_16x16x32_bf16 v[180:183], v[196:199], v[48:51], 0
v_mfma_f32_16x16x32_bf16 v[184:187], v[196:199], v[52:55], 0
s_nop 1
v_mfma_f32_16x16x32_bf16 v[188:191], v[196:199], v[56:59], 0
v_mfma_f32_16x16x32_bf16 v[192:195], v[196:199], v[60:63], 0
s_nop 7
v_mfma_f32_16x16x16_bf16 v[164:167], v[200:201], v[160:161], v[164:167]
v_mfma_f32_16x16x16_bf16 v[168:171], v[202:203], v[160:161], v[168:171]
v_mfma_f32_16x16x16_bf16 v[172:175], v[204:205], v[160:161], v[172:175]
v_mfma_f32_16x16x16_bf16 v[176:179], v[206:207], v[160:161], v[176:179]
v_mfma_f32_16x16x16_bf16 v[180:183], v[200:201], v[162:163], v[180:183]
v_mfma_f32_16x16x16_bf16 v[184:187], v[202:203], v[162:163], v[184:187]
v_mfma_f32_16x16x16_bf16 v[188:191], v[204:205], v[162:163], v[188:191]
v_mfma_f32_16x16x16_bf16 v[192:195], v[206:207], v[162:163], v[192:195]
v_cmp_le_u32 vcc, 8, v1
v_lshrrev_b32 v9, 3, v1
s_lshl_b32 s70, s20, 1
v_add_u32 v9, s70, v9
v_lshlrev_b32 v9, 9, v9
v_and_b32 v10, 7, v1
v_lshl_add_u32 v9, v10, 5, v9
s_nop 7
v_cndmask_b32 v128, v164, v166, vcc
v_cndmask_b32 v129, v168, v170, vcc
v_cndmask_b32 v130, v172, v174, vcc
v_cndmask_b32 v131, v176, v178, vcc
v_cndmask_b32 v132, v180, v182, vcc
v_cndmask_b32 v133, v184, v186, vcc
v_cndmask_b32 v134, v188, v190, vcc
v_cndmask_b32 v135, v192, v194, vcc
v_cndmask_b32 v136, v165, v167, vcc
v_cndmask_b32 v137, v169, v171, vcc
v_cndmask_b32 v138, v173, v175, vcc
v_cndmask_b32 v139, v177, v179, vcc
v_cndmask_b32 v140, v181, v183, vcc
v_cndmask_b32 v141, v185, v187, vcc
v_cndmask_b32 v142, v189, v191, vcc
v_cndmask_b32 v143, v193, v195, vcc
s_mov_b64 exec, 0xffff
ds_write_b128 v9, v[128:131] offset:0
ds_write_b128 v9, v[132:135] offset:16
ds_write_b128 v9, v[136:139] offset:256
ds_write_b128 v9, v[140:143] offset:272
s_mov_b64 exec, -1
s_waitcnt lgkmcnt(0)
s_mov_b64 exec, 1
ds_add_rtn_u32 v9, v30, v31 offset:4864
s_mov_b64 exec, -1
s_add_u32 s23, s23, 1
v_lshlrev_b32 v10, 2, v0
v_lshlrev_b32 v11, 4, v0
v_mov_b32 v13, s23
v_mov_b32 v15, s23
s_lshl_b32 s70, s3, 13
s_lshl_b32 s71, s22, 10
s_add_u32 s70, s70, s71
s_lshl_b32 s71, s21, 3
s_add_u32 s70, s70, s71
s_add_u32 s70, s70, 0
s_add_u32 s71, s70, 4096
s_waitcnt lgkmcnt(0)
v_readfirstlane_b32 s72, v9
s_cmp_lg_u32 s72, 3
s_cbranch_scc1 L_qskip1
ds_read2st64_b32 v[128:129], v10 offset0:0 offset1:1
ds_read2st64_b32 v[130:131], v10 offset0:2 offset1:3
ds_read2st64_b32 v[132:133], v10 offset0:4 offset1:5
ds_read2st64_b32 v[134:135], v10 offset0:6 offset1:7
ds_read2st64_b32 v[136:137], v10 offset0:8 offset1:9
ds_read2st64_b32 v[138:139], v10 offset0:10 offset1:11
ds_read2st64_b32 v[140:141], v10 offset0:12 offset1:13
ds_read2st64_b32 v[142:143], v10 offset0:14 offset1:15
s_waitcnt lgkmcnt(0)
v_add_f32 v128, v128, v136
v_add_f32 v129, v129, v137
v_add_f32 v130, v130, v138
v_add_f32 v131, v131, v139
v_add_f32 v132, v132, v140
v_add_f32 v133, v133, v141
v_add_f32 v134, v134, v142
v_add_f32 v135, v135, v143
v_add_f32 v128, v128, v132
v_add_f32 v129, v129, v133
v_add_f32 v130, v130, v134
v_add_f32 v131, v131, v135
v_add_f32 v12, v128, v130
v_add_f32 v14, v129, v131
buffer_store_dwordx2 v[12:13], v11, s[40:43], s70 offen sc1
buffer_store_dwordx2 v[14:15], v11, s[40:43], s71 offen sc1
L_qskip1:
s_waitcnt vmcnt(9)
buffer_load_dwordx4 a[40:43], v3, s[24:27], s50 offen offset:128 nt
s_waitcnt vmcnt(9)
buffer_load_dwordx4 a[44:47], v3, s[24:27], s50 offen offset:192 nt
s_waitcnt vmcnt(9)
buffer_load_dwordx4 a[48:51], v3, s[24:27], s51 offen offset:0 nt
s_waitcnt vmcnt(9)
buffer_load_dwordx4 a[52:55], v3, s[24:27], s51 offen offset:64 nt
s_waitcnt vmcnt(9)
buffer_load_dwordx4 a[56:59], v3, s[24:27], s51 offen offset:128 nt
s_waitcnt vmcnt(9)
buffer_load_dwordx4 a[60:63], v3, s[24:27], s51 offen offset:192 nt
s_waitcnt vmcnt(9)
buffer_load_dwordx4 a[64:67], v3, s[24:27], s52 offen offset:0 nt
s_waitcnt vmcnt(9)
buffer_load_dwordx4 a[68:71], v3, s[24:27], s52 offen offset:64 nt
s_waitcnt vmcnt(9)
buffer_load_dwordx4 a[72:75], v3, s[24:27], s52 offen offset:128 nt
s_waitcnt vmcnt(9)
buffer_load_dwordx4 a[76:79], v3, s[24:27], s52 offen offset:192 nt
s_waitcnt vmcnt(9)
buffer_load_dwordx4 a[80:83], v3, s[24:27], s53 offen offset:0 nt
s_waitcnt vmcnt(9)
buffer_load_dwordx4 a[84:87], v3, s[24:27], s53 offen offset:64 nt
s_waitcnt vmcnt(9)
buffer_load_dwordx4 a[88:91], v3, s[24:27], s53 offen offset:128 nt
s_waitcnt vmcnt(9)
buffer_load_dwordx4 a[92:95], v3, s[24:27], s53 offen offset:192 nt
s_waitcnt vmcnt(9)
buffer_load_dwordx4 a[96:99], v3, s[24:27], s54 offen offset:0 nt
s_waitcnt vmcnt(9)
buffer_load_dwordx4 a[100:103], v3, s[24:27], s54 offen offset:64 nt
s_waitcnt vmcnt(9)
buffer_load_dwordx4 a[104:107], v3, s[24:27], s54 offen offset:128 nt
s_waitcnt vmcnt(9)
buffer_load_dwordx4 a[108:111], v3, s[24:27], s54 offen offset:192 nt
s_waitcnt vmcnt(9)
buffer_load_dwordx4 a[112:115], v3, s[24:27], s55 offen offset:0 nt
s_waitcnt vmcnt(9)
buffer_load_dwordx4 a[116:119], v3, s[24:27], s55 offen offset:64 nt
s_waitcnt vmcnt(9)
buffer_load_dwordx4 a[120:123], v3, s[24:27], s55 offen offset:128 nt
s_waitcnt vmcnt(9)
buffer_load_dwordx4 a[124:127], v3, s[24:27], s55 offen offset:192 nt
s_waitcnt vmcnt(9)
buffer_load_dwordx4 v[128:131], v4, s[28:31], s48 offen offset:0 nt
s_waitcnt vmcnt(9)
buffer_load_dwordx4 v[132:135], v4, s[28:31], s48 offen offset:256 nt
s_waitcnt vmcnt(9)
buffer_load_dwordx4 v[136:139], v4, s[28:31], s48 offen offset:512 nt
s_waitcnt vmcnt(9)
buffer_load_dwordx4 v[140:143], v4, s[28:31], s48 offen offset:768 nt
s_waitcnt vmcnt(9)
buffer_load_dwordx4 v[144:147], v4, s[28:31], s49 offen offset:0 nt
s_waitcnt vmcnt(9)
buffer_load_dwordx4 v[148:151], v4, s[28:31], s49 offen offset:256 nt
s_waitcnt vmcnt(9)
buffer_load_dwordx4 v[152:155], v4, s[28:31], s49 offen offset:512 nt
s_waitcnt vmcnt(9)
buffer_load_dwordx4 v[156:159], v4, s[28:31], s49 offen offset:768 nt
s_waitcnt vmcnt(9)
buffer_load_dwordx4 v[160:163], v4, s[28:31], s50 offen offset:0 nt
s_waitcnt vmcnt(9)
buffer_load_dwordx4 v[164:167], v4, s[28:31], s50 offen offset:256 nt
s_waitcnt vmcnt(9)
buffer_load_dwordx4 v[168:171], v4, s[28:31], s50 offen offset:512 nt
s_waitcnt vmcnt(9)
buffer_load_dwordx4 v[172:175], v4, s[28:31], s50 offen offset:768 nt
s_waitcnt vmcnt(9)
buffer_load_dwordx4 v[176:179], v4, s[28:31], s51 offen offset:0 nt
s_lshl_b32 s78, s3, 1
s_add_u32 s78, s78, s21
s_lshl_b32 s78, s78, 12
s_lshl_b32 s70, s20, 10
s_add_u32 s78, s78, s70
s_add_u32 s78, s78, 0
buffer_load_dwordx4 v[16:19], v11, s[40:43], s78 offen sc1
s_waitcnt vmcnt(9)
buffer_load_dwordx4 v[180:183], v4, s[28:31], s51 offen offset:256 nt
s_waitcnt vmcnt(9)
buffer_load_dwordx4 v[184:187], v4, s[28:31], s51 offen offset:512 nt
s_waitcnt vmcnt(9)
buffer_load_dwordx4 v[188:191], v4, s[28:31], s51 offen offset:768 nt
s_waitcnt vmcnt(9)
buffer_load_dwordx4 v[192:195], v4, s[28:31], s52 offen offset:0 nt
s_waitcnt vmcnt(9)
buffer_load_dwordx4 v[196:199], v4, s[28:31], s52 offen offset:256 nt
s_waitcnt vmcnt(9)
buffer_load_dwordx4 v[200:203], v4, s[28:31], s52 offen offset:512 nt
s_waitcnt vmcnt(9)
buffer_load_dwordx4 v[204:207], v4, s[28:31], s52 offen offset:768 nt
s_waitcnt vmcnt(9)
buffer_load_dwordx4 v[208:211], v4, s[28:31], s53 offen offset:0 nt
s_waitcnt vmcnt(9)
buffer_load_dwordx4 v[212:215], v4, s[28:31], s53 offen offset:256 nt
s_waitcnt vmcnt(9)
buffer_load_dwordx4 v[216:219], v4, s[28:31], s53 offen offset:512 nt
s_waitcnt vmcnt(10)
s_mov_b32 s79, 200000
L_qchk2:
v_cmp_ne_u32 vcc, s23, v17
v_cmp_ne_u32 s[70:71], s23, v19
s_or_b64 vcc, vcc, s[70:71]
s_cbranch_vccz L_qok3
s_sub_u32 s79, s79, 1
s_cbranch_scc1 L_qok3
buffer_load_dwordx4 v[16:19], v11, s[40:43], s78 offen sc1
s_waitcnt vmcnt(0)
s_branch L_qchk2
L_qok3:
v_add_f32 v16, v16, v18
s_lshl_b32 s70, s20, 7
v_lshl_add_u32 v15, v0, 1, s70
v_cvt_pk_bf16_f32 v16, v16, v16
ds_write_b16 v15, v16 offset:4096
s_waitcnt lgkmcnt(0)
s_mov_b64 exec, 1
ds_add_u32 v30, v31 offset:4868
s_mov_b64 exec, -1
s_waitcnt vmcnt(9)
buffer_load_dwordx4 v[220:223], v4, s[28:31], s53 offen offset:768 nt
v_and_b32 v15, 1, v1
v_lshlrev_b32 v15, 8, v15
v_lshl_add_u32 v15, v2, 4, v15
L_quse4:
ds_read_b32 v9, v30 offset:4868
s_waitcnt lgkmcnt(0)
v_readfirstlane_b32 s72, v9
s_cmp_lg_u32 s72, 4
s_cbranch_scc1 L_quse4
ds_read_b128 v[32:35], v15 offset:4096
ds_read_b128 v[36:39], v15 offset:4160
ds_read_b128 v[40:43], v15 offset:4224
ds_read_b128 v[44:47], v15 offset:4288
s_waitcnt lgkmcnt(0)
v_mov_b32 v12, 1
s_mov_b64 exec, 1
buffer_atomic_add v12, v30, s[40:43], s57 offen sc0 sc1
s_mov_b64 exec, -1
s_waitcnt vmcnt(9)
buffer_load_dwordx4 v[224:227], v4, s[28:31], s54 offen offset:0 nt
s_waitcnt vmcnt(55)
v_mfma_f32_16x16x32_bf16 v[64:67], a[0:3], v[32:35], 0
v_mfma_f32_16x16x32_bf16 v[64:67], a[4:7], v[36:39], v[64:67]
v_mfma_f32_16x16x32_bf16 v[64:67], a[8:11], v[40:43], v[64:67]
v_mfma_f32_16x16x32_bf16 v[64:67], a[12:15], v[44:47], v[64:67]
s_waitcnt vmcnt(51)
v_mfma_f32_16x16x32_bf16 v[68:71], a[16:19], v[32:35], 0
v_mfma_f32_16x16x32_bf16 v[68:71], a[20:23], v[36:39], v[68:71]
v_mfma_f32_16x16x32_bf16 v[68:71], a[24:27], v[40:43], v[68:71]
v_mfma_f32_16x16x32_bf16 v[68:71], a[28:31], v[44:47], v[68:71]
s_waitcnt vmcnt(47)
v_mfma_f32_16x16x32_bf16 v[72:75], a[32:35], v[32:35], 0
v_mfma_f32_16x16x32_bf16 v[72:75], a[36:39], v[36:39], v[72:75]
v_mfma_f32_16x16x32_bf16 v[72:75], a[40:43], v[40:43], v[72:75]
v_mfma_f32_16x16x32_bf16 v[72:75], a[44:47], v[44:47], v[72:75]
s_waitcnt vmcnt(43)
v_mfma_f32_16x16x32_bf16 v[76:79], a[48:51], v[32:35], 0
v_mfma_f32_16x16x32_bf16 v[76:79], a[52:55], v[36:39], v[76:79]
v_mfma_f32_16x16x32_bf16 v[76:79], a[56:59], v[40:43], v[76:79]
v_mfma_f32_16x16x32_bf16 v[76:79], a[60:63], v[44:47], v[76:79]
s_waitcnt vmcnt(9)
buffer_load_dwordx4 v[228:231], v4, s[28:31], s54 offen offset:256 nt
s_waitcnt vmcnt(40)
v_mfma_f32_16x16x32_bf16 v[80:83], a[64:67], v[32:35], 0
v_mfma_f32_16x16x32_bf16 v[80:83], a[68:71], v[36:39], v[80:83]
v_mfma_f32_16x16x32_bf16 v[80:83], a[72:75], v[40:43], v[80:83]
v_mfma_f32_16x16x32_bf16 v[80:83], a[76:79], v[44:47], v[80:83]
s_waitcnt vmcnt(36)
v_mfma_f32_16x16x32_bf16 v[84:87], a[80:83], v[32:35], 0
v_mfma_f32_16x16x32_bf16 v[84:87], a[84:87], v[36:39], v[84:87]
v_mfma_f32_16x16x32_bf16 v[84:87], a[88:91], v[40:43], v[84:87]
v_mfma_f32_16x16x32_bf16 v[84:87], a[92:95], v[44:47], v[84:87]
s_waitcnt vmcnt(32)
v_mfma_f32_16x16x32_bf16 v[88:91], a[96:99], v[32:35], 0
v_mfma_f32_16x16x32_bf16 v[88:91], a[100:103], v[36:39], v[88:91]
v_mfma_f32_16x16x32_bf16 v[88:91], a[104:107], v[40:43], v[88:91]
v_mfma_f32_16x16x32_bf16 v[88:91], a[108:111], v[44:47], v[88:91]
s_waitcnt vmcnt(28)
v_mfma_f32_16x16x32_bf16 v[92:95], a[112:115], v[32:35], 0
v_mfma_f32_16x16x32_bf16 v[92:95], a[116:119], v[36:39], v[92:95]
v_mfma_f32_16x16x32_bf16 v[92:95], a[120:123], v[40:43], v[92:95]
v_mfma_f32_16x16x32_bf16 v[92:95], a[124:127], v[44:47], v[92:95]
s_waitcnt vmcnt(9)
buffer_load_dwordx4 v[232:235], v4, s[28:31], s54 offen offset:512 nt
s_nop 7
v_max3_f32 v9, v64, v65, v66
v_max3_f32 v10, v67, v68, v69
v_max3_f32 v9, v9, v70, v71
v_max3_f32 v10, v10, v72, v73
v_max3_f32 v9, v9, v74, v75
v_max3_f32 v10, v10, v76, v77
v_max3_f32 v9, v9, v78, v79
v_max3_f32 v10, v10, v80, v81
v_max3_f32 v9, v9, v82, v83
v_max3_f32 v10, v10, v84, v85
v_max3_f32 v9, v9, v86, v87
v_max3_f32 v10, v10, v88, v89
v_max3_f32 v9, v9, v90, v91
v_max3_f32 v10, v10, v92, v93
v_max3_f32 v9, v9, v94, v95
v_max_f32 v9, v9, v10
v_mov_b32 v10, v9
s_nop 1
v_permlane32_swap_b32 v9, v10
s_nop 1
v_max_f32 v9, v9, v10
v_mov_b32 v10, v9
s_nop 1
v_permlane16_swap_b32 v9, v10
s_nop 1
v_max_f32 v20, v9, v10
v_mov_b32 v23, 0
v_mov_b32 v24, 0
v_mul_f32 v22, s68, v20
s_waitcnt vmcnt(9)
buffer_load_dwordx4 v[236:239], v4, s[28:31], s54 offen offset:768 nt
v_fma_f32 v64, v64, s68, -v22
v_fma_f32 v65, v65, s68, -v22
v_fma_f32 v66, v66, s68, -v22
v_fma_f32 v67, v67, s68, -v22
v_fma_f32 v68, v68, s68, -v22
v_fma_f32 v69, v69, s68, -v22
v_fma_f32 v70, v70, s68, -v22
v_fma_f32 v71, v71, s68, -v22
v_exp_f32 v64, v64
v_exp_f32 v65, v65
v_exp_f32 v66, v66
v_exp_f32 v67, v67
v_exp_f32 v68, v68
v_exp_f32 v69, v69
v_exp_f32 v70, v70
v_exp_f32 v71, v71
v_add_f32 v23, v23, v64
v_add_f32 v24, v24, v65
v_add_f32 v23, v23, v66
v_add_f32 v24, v24, v67
v_add_f32 v23, v23, v68
v_add_f32 v24, v24, v69
v_add_f32 v23, v23, v70
v_add_f32 v24, v24, v71
v_cvt_pk_bf16_f32 v64, v64, v65
v_cvt_pk_bf16_f32 v65, v66, v67
v_cvt_pk_bf16_f32 v66, v68, v69
v_cvt_pk_bf16_f32 v67, v70, v71
v_fma_f32 v72, v72, s68, -v22
v_fma_f32 v73, v73, s68, -v22
v_fma_f32 v74, v74, s68, -v22
v_fma_f32 v75, v75, s68, -v22
v_fma_f32 v76, v76, s68, -v22
v_fma_f32 v77, v77, s68, -v22
v_fma_f32 v78, v78, s68, -v22
v_fma_f32 v79, v79, s68, -v22
v_exp_f32 v72, v72
v_exp_f32 v73, v73
v_exp_f32 v74, v74
v_exp_f32 v75, v75
v_exp_f32 v76, v76
v_exp_f32 v77, v77
v_exp_f32 v78, v78
v_exp_f32 v79, v79
v_add_f32 v23, v23, v72
v_add_f32 v24, v24, v73
v_add_f32 v23, v23, v74
v_add_f32 v24, v24, v75
v_add_f32 v23, v23, v76
v_add_f32 v24, v24, v77
v_add_f32 v23, v23, v78
v_add_f32 v24, v24, v79
v_cvt_pk_bf16_f32 v68, v72, v73
v_cvt_pk_bf16_f32 v69, v74, v75
v_cvt_pk_bf16_f32 v70, v76, v77
v_cvt_pk_bf16_f32 v71, v78, v79
s_waitcnt vmcnt(9)
buffer_load_dwordx4 v[240:243], v4, s[28:31], s55 offen offset:0 nt
v_fma_f32 v80, v80, s68, -v22
v_fma_f32 v81, v81, s68, -v22
v_fma_f32 v82, v82, s68, -v22
v_fma_f32 v83, v83, s68, -v22
v_fma_f32 v84, v84, s68, -v22
v_fma_f32 v85, v85, s68, -v22
v_fma_f32 v86, v86, s68, -v22
v_fma_f32 v87, v87, s68, -v22
v_exp_f32 v80, v80
v_exp_f32 v81, v81
v_exp_f32 v82, v82
v_exp_f32 v83, v83
v_exp_f32 v84, v84
v_exp_f32 v85, v85
v_exp_f32 v86, v86
v_exp_f32 v87, v87
v_add_f32 v23, v23, v80
v_add_f32 v24, v24, v81
v_add_f32 v23, v23, v82
v_add_f32 v24, v24, v83
v_add_f32 v23, v23, v84
v_add_f32 v24, v24, v85
v_add_f32 v23, v23, v86
v_add_f32 v24, v24, v87
v_cvt_pk_bf16_f32 v72, v80, v81
v_cvt_pk_bf16_f32 v73, v82, v83
v_cvt_pk_bf16_f32 v74, v84, v85
v_cvt_pk_bf16_f32 v75, v86, v87
v_fma_f32 v88, v88, s68, -v22
v_fma_f32 v89, v89, s68, -v22
v_fma_f32 v90, v90, s68, -v22
v_fma_f32 v91, v91, s68, -v22
v_fma_f32 v92, v92, s68, -v22
v_fma_f32 v93, v93, s68, -v22
v_fma_f32 v94, v94, s68, -v22
v_fma_f32 v95, v95, s68, -v22
v_exp_f32 v88, v88
v_exp_f32 v89, v89
v_exp_f32 v90, v90
v_exp_f32 v91, v91
v_exp_f32 v92, v92
v_exp_f32 v93, v93
v_exp_f32 v94, v94
v_exp_f32 v95, v95
v_add_f32 v23, v23, v88
v_add_f32 v24, v24, v89
v_add_f32 v23, v23, v90
v_add_f32 v24, v24, v91
v_add_f32 v23, v23, v92
v_add_f32 v24, v24, v93
v_add_f32 v23, v23, v94
v_add_f32 v24, v24, v95
v_cvt_pk_bf16_f32 v76, v88, v89
v_cvt_pk_bf16_f32 v77, v90, v91
v_cvt_pk_bf16_f32 v78, v92, v93
v_cvt_pk_bf16_f32 v79, v94, v95
s_waitcnt vmcnt(9)
buffer_load_dwordx4 v[244:247], v4, s[28:31], s55 offen offset:256 nt
s_waitcnt vmcnt(24)
v_perm_b32 v48, v132, v128, s66
v_perm_b32 v49, v140, v136, s66
v_perm_b32 v50, v148, v144, s66
v_perm_b32 v51, v156, v152, s66
v_perm_b32 v52, v132, v128, s67
v_perm_b32 v53, v140, v136, s67
v_perm_b32 v54, v148, v144, s67
v_perm_b32 v55, v156, v152, s67
v_perm_b32 v56, v133, v129, s66
v_perm_b32 v57, v141, v137, s66
v_perm_b32 v58, v149, v145, s66
v_perm_b32 v59, v157, v153, s66
v_perm_b32 v60, v133, v129, s67
v_perm_b32 v61, v141, v137, s67
v_perm_b32 v62, v149, v145, s67
v_perm_b32 v63, v157, v153, s67
v_mfma_f32_16x16x32_bf16 v[96:99], v[64:67], v[48:51], 0
v_mfma_f32_16x16x32_bf16 v[100:103], v[64:67], v[52:55], 0
v_perm_b32 v48, v134, v130, s66
v_perm_b32 v49, v142, v138, s66
v_perm_b32 v50, v150, v146, s66
v_perm_b32 v51, v158, v154, s66
v_perm_b32 v52, v134, v130, s67
v_perm_b32 v53, v142, v138, s67
v_perm_b32 v54, v150, v146, s67
v_perm_b32 v55, v158, v154, s67
v_mfma_f32_16x16x32_bf16 v[104:107], v[64:67], v[56:59], 0
v_mfma_f32_16x16x32_bf16 v[108:111], v[64:67], v[60:63], 0
v_perm_b32 v56, v135, v131, s66
v_perm_b32 v57, v143, v139, s66
v_perm_b32 v58, v151, v147, s66
v_perm_b32 v59, v159, v155, s66
v_perm_b32 v60, v135, v131, s67
v_perm_b32 v61, v143, v139, s67
v_perm_b32 v62, v151, v147, s67
v_perm_b32 v63, v159, v155, s67
v_mfma_f32_16x16x32_bf16 v[112:115], v[64:67], v[48:51], 0
v_mfma_f32_16x16x32_bf16 v[116:119], v[64:67], v[52:55], 0
s_nop 1
v_mfma_f32_16x16x32_bf16 v[120:123], v[64:67], v[56:59], 0
v_mfma_f32_16x16x32_bf16 v[124:127], v[64:67], v[60:63], 0
s_waitcnt vmcnt(9)
buffer_load_dwordx4 v[248:251], v4, s[28:31], s55 offen offset:512 nt
s_waitcnt vmcnt(16)
v_perm_b32 v48, v164, v160, s66
v_perm_b32 v49, v172, v168, s66
v_perm_b32 v50, v180, v176, s66
v_perm_b32 v51, v188, v184, s66
v_perm_b32 v52, v164, v160, s67
v_perm_b32 v53, v172, v168, s67
v_perm_b32 v54, v180, v176, s67
v_perm_b32 v55, v188, v184, s67
v_perm_b32 v56, v165, v161, s66
v_perm_b32 v57, v173, v169, s66
v_perm_b32 v58, v181, v177, s66
v_perm_b32 v59, v189, v185, s66
v_perm_b32 v60, v165, v161, s67
v_perm_b32 v61, v173, v169, s67
v_perm_b32 v62, v181, v177, s67
v_perm_b32 v63, v189, v185, s67
v_mfma_f32_16x16x32_bf16 v[96:99], v[68:71], v[48:51], v[96:99]
v_mfma_f32_16x16x32_bf16 v[100:103], v[68:71], v[52:55], v[100:103]
v_perm_b32 v48, v166, v162, s66
v_perm_b32 v49, v174, v170, s66
v_perm_b32 v50, v182, v178, s66
v_perm_b32 v51, v190, v186, s66
v_perm_b32 v52, v166, v162, s67
v_perm_b32 v53, v174, v170, s67
v_perm_b32 v54, v182, v178, s67
v_perm_b32 v55, v190, v186, s67
v_mfma_f32_16x16x32_bf16 v[104:107], v[68:71], v[56:59], v[104:107]
v_mfma_f32_16x16x32_bf16 v[108:111], v[68:71], v[60:63], v[108:111]
v_perm_b32 v56, v167, v163, s66
v_perm_b32 v57, v175, v171, s66
v_perm_b32 v58, v183, v179, s66
v_perm_b32 v59, v191, v187, s66
v_perm_b32 v60, v167, v163, s67
v_perm_b32 v61, v175, v171, s67
v_perm_b32 v62, v183, v179, s67
v_perm_b32 v63, v191, v187, s67
v_mfma_f32_16x16x32_bf16 v[112:115], v[68:71], v[48:51], v[112:115]
v_mfma_f32_16x16x32_bf16 v[116:119], v[68:71], v[52:55], v[116:119]
s_nop 1
v_mfma_f32_16x16x32_bf16 v[120:123], v[68:71], v[56:59], v[120:123]
v_mfma_f32_16x16x32_bf16 v[124:127], v[68:71], v[60:63], v[124:127]
s_waitcnt vmcnt(9)
buffer_load_dwordx4 v[252:255], v4, s[28:31], s55 offen offset:768 nt
s_waitcnt vmcnt(9)
v_perm_b32 v48, v196, v192, s66
v_perm_b32 v49, v204, v200, s66
v_perm_b32 v50, v212, v208, s66
v_perm_b32 v51, v220, v216, s66
v_perm_b32 v52, v196, v192, s67
v_perm_b32 v53, v204, v200, s67
v_perm_b32 v54, v212, v208, s67
v_perm_b32 v55, v220, v216, s67
v_perm_b32 v56, v197, v193, s66
v_perm_b32 v57, v205, v201, s66
v_perm_b32 v58, v213, v209, s66
v_perm_b32 v59, v221, v217, s66
v_perm_b32 v60, v197, v193, s67
v_perm_b32 v61, v205, v201, s67
v_perm_b32 v62, v213, v209, s67
v_perm_b32 v63, v221, v217, s67
v_mfma_f32_16x16x32_bf16 v[96:99], v[72:75], v[48:51], v[96:99]
v_mfma_f32_16x16x32_bf16 v[100:103], v[72:75], v[52:55], v[100:103]
v_perm_b32 v48, v198, v194, s66
v_perm_b32 v49, v206, v202, s66
v_perm_b32 v50, v214, v210, s66
v_perm_b32 v51, v222, v218, s66
v_perm_b32 v52, v198, v194, s67
v_perm_b32 v53, v206, v202, s67
v_perm_b32 v54, v214, v210, s67
v_perm_b32 v55, v222, v218, s67
v_mfma_f32_16x16x32_bf16 v[104:107], v[72:75], v[56:59], v[104:107]
v_mfma_f32_16x16x32_bf16 v[108:111], v[72:75], v[60:63], v[108:111]
v_perm_b32 v56, v199, v195, s66
v_perm_b32 v57, v207, v203, s66
v_perm_b32 v58, v215, v211, s66
v_perm_b32 v59, v223, v219, s66
v_perm_b32 v60, v199, v195, s67
v_perm_b32 v61, v207, v203, s67
v_perm_b32 v62, v215, v211, s67
v_perm_b32 v63, v223, v219, s67
v_mfma_f32_16x16x32_bf16 v[112:115], v[72:75], v[48:51], v[112:115]
v_mfma_f32_16x16x32_bf16 v[116:119], v[72:75], v[52:55], v[116:119]
s_nop 1
v_mfma_f32_16x16x32_bf16 v[120:123], v[72:75], v[56:59], v[120:123]
v_mfma_f32_16x16x32_bf16 v[124:127], v[72:75], v[60:63], v[124:127]
s_mov_b32 s56, 0
s_waitcnt vmcnt(8)
L_dyn:
s_waitcnt vmcnt(15)
v_readfirstlane_b32 s70, v12
s_cmp_ge_u32 s70, 64
s_cbranch_scc1 L_dexit
s_lshl_b32 s70, s70, 13
s_add_u32 s48, s70, s15
s_and_b32 s48, s48, 0xfffff
s_add_u32 s49, s48, 0x1000
s_waitcnt vmcnt(15)
buffer_load_dwordx4 a[128:131], v3, s[24:27], s48 offen offset:0 nt
v_mov_b32 v12, 1
s_mov_b64 exec, 1
buffer_atomic_add v12, v30, s[40:43], s57 offen sc0 sc1
s_mov_b64 exec, -1
s_waitcnt vmcnt(15)
buffer_load_dwordx4 a[132:135], v3, s[24:27], s48 offen offset:64 nt
s_waitcnt vmcnt(15)
buffer_load_dwordx4 a[136:139], v3, s[24:27], s48 offen offset:128 nt
s_waitcnt vmcnt(15)
buffer_load_dwordx4 a[140:143], v3, s[24:27], s48 offen offset:192 nt
s_waitcnt vmcnt(15)
buffer_load_dwordx4 a[144:147], v3, s[24:27], s49 offen offset:0 nt
s_waitcnt vmcnt(15)
buffer_load_dwordx4 a[148:151], v3, s[24:27], s49 offen offset:64 nt
s_waitcnt vmcnt(15)
buffer_load_dwordx4 a[152:155], v3, s[24:27], s49 offen offset:128 nt
s_waitcnt vmcnt(15)
buffer_load_dwordx4 a[156:159], v3, s[24:27], s49 offen offset:192 nt
s_cmp_eq_u32 s56, 0
s_cbranch_scc1 L_sk7
s_waitcnt vmcnt(17)
v_mfma_f32_16x16x32_bf16 v[80:83], a[160:163], v[32:35], 0
v_mfma_f32_16x16x32_bf16 v[80:83], a[164:167], v[36:39], v[80:83]
v_mfma_f32_16x16x32_bf16 v[80:83], a[168:171], v[40:43], v[80:83]
v_mfma_f32_16x16x32_bf16 v[80:83], a[172:175], v[44:47], v[80:83]
v_mfma_f32_16x16x32_bf16 v[84:87], a[176:179], v[32:35], 0
v_mfma_f32_16x16x32_bf16 v[84:87], a[180:183], v[36:39], v[84:87]
v_mfma_f32_16x16x32_bf16 v[84:87], a[184:187], v[40:43], v[84:87]
v_mfma_f32_16x16x32_bf16 v[84:87], a[188:191], v[44:47], v[84:87]
L_sk7:
s_waitcnt vmcnt(15)
buffer_load_dwordx4 v[192:195], v4, s[28:31], s48 offen offset:0 nt
s_cmp_eq_u32 s56, 0
s_cbranch_scc1 L_sk8
s_nop 7
v_max3_f32 v9, v80, v81, v82
v_max3_f32 v10, v83, v84, v85
v_max3_f32 v9, v9, v86, v87
v_max_f32 v9, v9, v10
v_mov_b32 v10, v9
s_nop 1
v_permlane32_swap_b32 v9, v10
s_nop 1
v_max_f32 v9, v9, v10
v_mov_b32 v10, v9
s_nop 1
v_permlane16_swap_b32 v9, v10
s_nop 1
v_max3_f32 v20, v9, v10, v20
v_mov_b32 v9, v22
v_mul_f32 v22, s68, v20
v_sub_f32 v9, v9, v22
v_exp_f32 v9, v9
v_fma_f32 v80, v80, s68, -v22
v_fma_f32 v81, v81, s68, -v22
v_fma_f32 v82, v82, s68, -v22
v_fma_f32 v83, v83, s68, -v22
v_fma_f32 v84, v84, s68, -v22
v_fma_f32 v85, v85, s68, -v22
v_fma_f32 v86, v86, s68, -v22
v_fma_f32 v87, v87, s68, -v22
L_sk8:
s_waitcnt vmcnt(15)
buffer_load_dwordx4 v[196:199], v4, s[28:31], s48 offen offset:256 nt
s_cmp_eq_u32 s56, 0
s_cbranch_scc1 L_sk9
v_exp_f32 v80, v80
v_exp_f32 v81, v81
v_exp_f32 v82, v82
v_exp_f32 v83, v83
v_exp_f32 v84, v84
v_exp_f32 v85, v85
v_exp_f32 v86, v86
v_exp_f32 v87, v87
v_mov_b32_dpp v10, v9 quad_perm:[0,0,0,0] row_mask:0xf bank_mask:0xf
v_mov_b32_dpp v13, v9 quad_perm:[1,1,1,1] row_mask:0xf bank_mask:0xf
v_fma_f32 v23, v23, v9, v80
v_fma_f32 v24, v24, v9, v81
v_add_f32 v23, v23, v82
v_add_f32 v24, v24, v83
v_add_f32 v23, v23, v84
v_add_f32 v24, v24, v85
v_add_f32 v23, v23, v86
v_add_f32 v24, v24, v87
v_cvt_pk_bf16_f32 v76, v80, v81
v_cvt_pk_bf16_f32 v77, v82, v83
v_cvt_pk_bf16_f32 v78, v84, v85
v_cvt_pk_bf16_f32 v79, v86, v87
v_mul_f32 v96, v96, v10
v_mul_f32 v97, v97, v13
v_mul_f32 v100, v100, v10
v_mul_f32 v101, v101, v13
v_mul_f32 v104, v104, v10
v_mul_f32 v105, v105, v13
v_mul_f32 v108, v108, v10
v_mul_f32 v109, v109, v13
v_mul_f32 v112, v112, v10
v_mul_f32 v113, v113, v13
v_mul_f32 v116, v116, v10
v_mul_f32 v117, v117, v13
v_mul_f32 v120, v120, v10
v_mul_f32 v121, v121, v13
v_mul_f32 v124, v124, v10
v_mul_f32 v125, v125, v13
L_sk9:
s_waitcnt vmcnt(15)
buffer_load_dwordx4 v[200:203], v4, s[28:31], s48 offen offset:512 nt
s_waitcnt vmcnt(15)
buffer_load_dwordx4 v[204:207], v4, s[28:31], s48 offen offset:768 nt
s_waitcnt vmcnt(15)
buffer_load_dwordx4 v[208:211], v4, s[28:31], s49 offen offset:0 nt
s_waitcnt vmcnt(15)
buffer_load_dwordx4 v[212:215], v4, s[28:31], s49 offen offset:256 nt
s_waitcnt vmcnt(15)
buffer_load_dwordx4 v[216:219], v4, s[28:31], s49 offen offset:512 nt
s_waitcnt vmcnt(15)
buffer_load_dwordx4 v[220:223], v4, s[28:31], s49 offen offset:768 nt
s_waitcnt vmcnt(17)
v_perm_b32 v48, v228, v224, s66
v_perm_b32 v49, v236, v232, s66
v_perm_b32 v50, v244, v240, s66
v_perm_b32 v51, v252, v248, s66
v_perm_b32 v52, v228, v224, s67
v_perm_b32 v53, v236, v232, s67
v_perm_b32 v54, v244, v240, s67
v_perm_b32 v55, v252, v248, s67
v_perm_b32 v56, v229, v225, s66
v_perm_b32 v57, v237, v233, s66
v_perm_b32 v58, v245, v241, s66
v_perm_b32 v59, v253, v249, s66
v_perm_b32 v60, v229, v225, s67
v_perm_b32 v61, v237, v233, s67
v_perm_b32 v62, v245, v241, s67
v_perm_b32 v63, v253, v249, s67
v_mfma_f32_16x16x32_bf16 v[96:99], v[76:79], v[48:51], v[96:99]
v_mfma_f32_16x16x32_bf16 v[100:103], v[76:79], v[52:55], v[100:103]
v_perm_b32 v48, v230, v226, s66
v_perm_b32 v49, v238, v234, s66
v_perm_b32 v50, v246, v242, s66
v_perm_b32 v51, v254, v250, s66
v_perm_b32 v52, v230, v226, s67
v_perm_b32 v53, v238, v234, s67
v_perm_b32 v54, v246, v242, s67
v_perm_b32 v55, v254, v250, s67
v_mfma_f32_16x16x32_bf16 v[104:107], v[76:79], v[56:59], v[104:107]
v_mfma_f32_16x16x32_bf16 v[108:111], v[76:79], v[60:63], v[108:111]
v_perm_b32 v56, v231, v227, s66
v_perm_b32 v57, v239, v235, s66
v_perm_b32 v58, v247, v243, s66
v_perm_b32 v59, v255, v251, s66
v_perm_b32 v60, v231, v227, s67
v_perm_b32 v61, v239, v235, s67
v_perm_b32 v62, v247, v243, s67
v_perm_b32 v63, v255, v251, s67
v_mfma_f32_16x16x32_bf16 v[112:115], v[76:79], v[48:51], v[112:115]
v_mfma_f32_16x16x32_bf16 v[116:119], v[76:79], v[52:55], v[116:119]
s_nop 1
v_mfma_f32_16x16x32_bf16 v[120:123], v[76:79], v[56:59], v[120:123]
v_mfma_f32_16x16x32_bf16 v[124:127], v[76:79], v[60:63], v[124:127]
s_add_u32 s56, s56, 1
s_waitcnt vmcnt(15)
v_readfirstlane_b32 s70, v12
s_cmp_ge_u32 s70, 64
s_cbranch_scc1 L_dexit
s_lshl_b32 s70, s70, 13
s_add_u32 s48, s70, s15
s_and_b32 s48, s48, 0xfffff
s_add_u32 s49, s48, 0x1000
s_waitcnt vmcnt(15)
buffer_load_dwordx4 a[160:163], v3, s[24:27], s48 offen offset:0 nt
v_mov_b32 v12, 1
s_mov_b64 exec, 1
buffer_atomic_add v12, v30, s[40:43], s57 offen sc0 sc1
s_mov_b64 exec, -1
s_waitcnt vmcnt(15)
buffer_load_dwordx4 a[164:167], v3, s[24:27], s48 offen offset:64 nt
s_waitcnt vmcnt(15)
buffer_load_dwordx4 a[168:171], v3, s[24:27], s48 offen offset:128 nt
s_waitcnt vmcnt(15)
buffer_load_dwordx4 a[172:175], v3, s[24:27], s48 offen offset:192 nt
s_waitcnt vmcnt(15)
buffer_load_dwordx4 a[176:179], v3, s[24:27], s49 offen offset:0 nt
s_waitcnt vmcnt(15)
buffer_load_dwordx4 a[180:183], v3, s[24:27], s49 offen offset:64 nt
s_waitcnt vmcnt(15)
buffer_load_dwordx4 a[184:187], v3, s[24:27], s49 offen offset:128 nt
s_waitcnt vmcnt(15)
buffer_load_dwordx4 a[188:191], v3, s[24:27], s49 offen offset:192 nt
s_waitcnt vmcnt(17)
v_mfma_f32_16x16x32_bf16 v[80:83], a[128:131], v[32:35], 0
v_mfma_f32_16x16x32_bf16 v[80:83], a[132:135], v[36:39], v[80:83]
v_mfma_f32_16x16x32_bf16 v[80:83], a[136:139], v[40:43], v[80:83]
v_mfma_f32_16x16x32_bf16 v[80:83], a[140:143], v[44:47], v[80:83]
v_mfma_f32_16x16x32_bf16 v[84:87], a[144:147], v[32:35], 0
v_mfma_f32_16x16x32_bf16 v[84:87], a[148:151], v[36:39], v[84:87]
v_mfma_f32_16x16x32_bf16 v[84:87], a[152:155], v[40:43], v[84:87]
v_mfma_f32_16x16x32_bf16 v[84:87], a[156:159], v[44:47], v[84:87]
s_waitcnt vmcnt(15)
buffer_load_dwordx4 v[224:227], v4, s[28:31], s48 offen offset:0 nt
s_nop 7
v_max3_f32 v9, v80, v81, v82
v_max3_f32 v10, v83, v84, v85
v_max3_f32 v9, v9, v86, v87
v_max_f32 v9, v9, v10
v_mov_b32 v10, v9
s_nop 1
v_permlane32_swap_b32 v9, v10
s_nop 1
v_max_f32 v9, v9, v10
v_mov_b32 v10, v9
s_nop 1
v_permlane16_swap_b32 v9, v10
s_nop 1
v_max3_f32 v20, v9, v10, v20
v_mov_b32 v9, v22
v_mul_f32 v22, s68, v20
v_sub_f32 v9, v9, v22
v_exp_f32 v9, v9
v_fma_f32 v80, v80, s68, -v22
v_fma_f32 v81, v81, s68, -v22
v_fma_f32 v82, v82, s68, -v22
v_fma_f32 v83, v83, s68, -v22
v_fma_f32 v84, v84, s68, -v22
v_fma_f32 v85, v85, s68, -v22
v_fma_f32 v86, v86, s68, -v22
v_fma_f32 v87, v87, s68, -v22
s_waitcnt vmcnt(15)
buffer_load_dwordx4 v[228:231], v4, s[28:31], s48 offen offset:256 nt
v_exp_f32 v80, v80
v_exp_f32 v81, v81
v_exp_f32 v82, v82
v_exp_f32 v83, v83
v_exp_f32 v84, v84
v_exp_f32 v85, v85
v_exp_f32 v86, v86
v_exp_f32 v87, v87
v_mov_b32_dpp v10, v9 quad_perm:[0,0,0,0] row_mask:0xf bank_mask:0xf
v_mov_b32_dpp v13, v9 quad_perm:[1,1,1,1] row_mask:0xf bank_mask:0xf
v_fma_f32 v23, v23, v9, v80
v_fma_f32 v24, v24, v9, v81
v_add_f32 v23, v23, v82
v_add_f32 v24, v24, v83
v_add_f32 v23, v23, v84
v_add_f32 v24, v24, v85
v_add_f32 v23, v23, v86
v_add_f32 v24, v24, v87
v_cvt_pk_bf16_f32 v76, v80, v81
v_cvt_pk_bf16_f32 v77, v82, v83
v_cvt_pk_bf16_f32 v78, v84, v85
v_cvt_pk_bf16_f32 v79, v86, v87
v_mul_f32 v96, v96, v10
v_mul_f32 v97, v97, v13
v_mul_f32 v100, v100, v10
v_mul_f32 v101, v101, v13
v_mul_f32 v104, v104, v10
v_mul_f32 v105, v105, v13
v_mul_f32 v108, v108, v10
v_mul_f32 v109, v109, v13
v_mul_f32 v112, v112, v10
v_mul_f32 v113, v113, v13
v_mul_f32 v116, v116, v10
v_mul_f32 v117, v117, v13
v_mul_f32 v120, v120, v10
v_mul_f32 v121, v121, v13
v_mul_f32 v124, v124, v10
v_mul_f32 v125, v125, v13
s_waitcnt vmcnt(15)
buffer_load_dwordx4 v[232:235], v4, s[28:31], s48 offen offset:512 nt
s_waitcnt vmcnt(15)
buffer_load_dwordx4 v[236:239], v4, s[28:31], s48 offen offset:768 nt
s_waitcnt vmcnt(15)
buffer_load_dwordx4 v[240:243], v4, s[28:31], s49 offen offset:0 nt
s_waitcnt vmcnt(15)
buffer_load_dwordx4 v[244:247], v4, s[28:31], s49 offen offset:256 nt
s_waitcnt vmcnt(15)
buffer_load_dwordx4 v[248:251], v4, s[28:31], s49 offen offset:512 nt
s_waitcnt vmcnt(15)
buffer_load_dwordx4 v[252:255], v4, s[28:31], s49 offen offset:768 nt
s_waitcnt vmcnt(17)
v_perm_b32 v48, v196, v192, s66
v_perm_b32 v49, v204, v200, s66
v_perm_b32 v50, v212, v208, s66
v_perm_b32 v51, v220, v216, s66
v_perm_b32 v52, v196, v192, s67
v_perm_b32 v53, v204, v200, s67
v_perm_b32 v54, v212, v208, s67
v_perm_b32 v55, v220, v216, s67
v_perm_b32 v56, v197, v193, s66
v_perm_b32 v57, v205, v201, s66
v_perm_b32 v58, v213, v209, s66
v_perm_b32 v59, v221, v217, s66
v_perm_b32 v60, v197, v193, s67
v_perm_b32 v61, v205, v201, s67
v_perm_b32 v62, v213, v209, s67
v_perm_b32 v63, v221, v217, s67
v_mfma_f32_16x16x32_bf16 v[96:99], v[76:79], v[48:51], v[96:99]
v_mfma_f32_16x16x32_bf16 v[100:103], v[76:79], v[52:55], v[100:103]
v_perm_b32 v48, v198, v194, s66
v_perm_b32 v49, v206, v202, s66
v_perm_b32 v50, v214, v210, s66
v_perm_b32 v51, v222, v218, s66
v_perm_b32 v52, v198, v194, s67
v_perm_b32 v53, v206, v202, s67
v_perm_b32 v54, v214, v210, s67
v_perm_b32 v55, v222, v218, s67
v_mfma_f32_16x16x32_bf16 v[104:107], v[76:79], v[56:59], v[104:107]
v_mfma_f32_16x16x32_bf16 v[108:111], v[76:79], v[60:63], v[108:111]
v_perm_b32 v56, v199, v195, s66
v_perm_b32 v57, v207, v203, s66
v_perm_b32 v58, v215, v211, s66
v_perm_b32 v59, v223, v219, s66
v_perm_b32 v60, v199, v195, s67
v_perm_b32 v61, v207, v203, s67
v_perm_b32 v62, v215, v211, s67
v_perm_b32 v63, v223, v219, s67
v_mfma_f32_16x16x32_bf16 v[112:115], v[76:79], v[48:51], v[112:115]
v_mfma_f32_16x16x32_bf16 v[116:119], v[76:79], v[52:55], v[116:119]
s_nop 1
v_mfma_f32_16x16x32_bf16 v[120:123], v[76:79], v[56:59], v[120:123]
v_mfma_f32_16x16x32_bf16 v[124:127], v[76:79], v[60:63], v[124:127]
s_add_u32 s56, s56, 1
s_branch L_dyn
L_dexit:
s_lshl_b32 s75, s3, 3
s_add_u32 s78, s75, s4
s_lshl_b32 s78, s78, 11
s_add_u32 s78, s78, 262144
s_and_b32 s6, s2, 7
s_lshl_b32 s6, s6, 1
s_bfe_u32 s4, s2, 0x10003
s_add_u32 s6, s6, s4
s_bfe_u32 s4, s2, 0x30004
s_mov_b32 s7, s4
s_lshl_b32 s3, s5, 4
s_add_u32 s3, s3, s6
s_lshl_b32 s70, s6, 8
s_lshl_b32 s71, s20, 6
s_add_u32 s70, s70, s71
s_mul_i32 s70, s70, 1152
s_mul_i32 s71, s7, 144
s_add_u32 s70, s70, s71
s_add_u32 s32, s16, s70
s_addc_u32 s33, s17, 0
s_sub_u32 s34, 4718592, s70
s_mov_b32 s35, 0x20000
v_mul_u32_u24 v5, 9216, v2
v_lshl_add_u32 v5, v1, 4, v5
s_cmp_eq_u32 s56, 0
s_cbranch_scc1 L_xsm
s_waitcnt vmcnt(8)
s_bitcmp1_b32 s56, 0
s_cbranch_scc1 L_xq0
v_mfma_f32_16x16x32_bf16 v[80:83], a[160:163], v[32:35], 0
v_mfma_f32_16x16x32_bf16 v[80:83], a[164:167], v[36:39], v[80:83]
v_mfma_f32_16x16x32_bf16 v[80:83], a[168:171], v[40:43], v[80:83]
v_mfma_f32_16x16x32_bf16 v[80:83], a[172:175], v[44:47], v[80:83]
v_mfma_f32_16x16x32_bf16 v[84:87], a[176:179], v[32:35], 0
v_mfma_f32_16x16x32_bf16 v[84:87], a[180:183], v[36:39], v[84:87]
v_mfma_f32_16x16x32_bf16 v[84:87], a[184:187], v[40:43], v[84:87]
v_mfma_f32_16x16x32_bf16 v[84:87], a[188:191], v[44:47], v[84:87]
s_branch L_xq1
L_xq0:
v_mfma_f32_16x16x32_bf16 v[80:83], a[128:131], v[32:35], 0
v_mfma_f32_16x16x32_bf16 v[80:83], a[132:135], v[36:39], v[80:83]
v_mfma_f32_16x16x32_bf16 v[80:83], a[136:139], v[40:43], v[80:83]
v_mfma_f32_16x16x32_bf16 v[80:83], a[140:143], v[44:47], v[80:83]
v_mfma_f32_16x16x32_bf16 v[84:87], a[144:147], v[32:35], 0
v_mfma_f32_16x16x32_bf16 v[84:87], a[148:151], v[36:39], v[84:87]
v_mfma_f32_16x16x32_bf16 v[84:87], a[152:155], v[40:43], v[84:87]
v_mfma_f32_16x16x32_bf16 v[84:87], a[156:159], v[44:47], v[84:87]
L_xq1:
s_nop 7
v_max3_f32 v9, v80, v81, v82
v_max3_f32 v10, v83, v84, v85
v_max3_f32 v9, v9, v86, v87
v_max_f32 v9, v9, v10
v_mov_b32 v10, v9
s_nop 1
v_permlane32_swap_b32 v9, v10
s_nop 1
v_max_f32 v9, v9, v10
v_mov_b32 v10, v9
s_nop 1
v_permlane16_swap_b32 v9, v10
s_nop 1
v_max3_f32 v20, v9, v10, v20
v_mov_b32 v9, v22
v_mul_f32 v22, s68, v20
v_sub_f32 v9, v9, v22
v_exp_f32 v9, v9
v_fma_f32 v80, v80, s68, -v22
v_fma_f32 v81, v81, s68, -v22
v_fma_f32 v82, v82, s68, -v22
v_fma_f32 v83, v83, s68, -v22
v_fma_f32 v84, v84, s68, -v22
v_fma_f32 v85, v85, s68, -v22
v_fma_f32 v86, v86, s68, -v22
v_fma_f32 v87, v87, s68, -v22
v_exp_f32 v80, v80
v_exp_f32 v81, v81
v_exp_f32 v82, v82
v_exp_f32 v83, v83
v_exp_f32 v84, v84
v_exp_f32 v85, v85
v_exp_f32 v86, v86
v_exp_f32 v87, v87
v_mov_b32_dpp v10, v9 quad_perm:[0,0,0,0] row_mask:0xf bank_mask:0xf
v_mov_b32_dpp v13, v9 quad_perm:[1,1,1,1] row_mask:0xf bank_mask:0xf
v_fma_f32 v23, v23, v9, v80
v_fma_f32 v24, v24, v9, v81
v_add_f32 v23, v23, v82
v_add_f32 v24, v24, v83
v_add_f32 v23, v23, v84
v_add_f32 v24, v24, v85
v_add_f32 v23, v23, v86
v_add_f32 v24, v24, v87
v_cvt_pk_bf16_f32 v76, v80, v81
v_cvt_pk_bf16_f32 v77, v82, v83
v_cvt_pk_bf16_f32 v78, v84, v85
v_cvt_pk_bf16_f32 v79, v86, v87
v_mul_f32 v96, v96, v10
v_mul_f32 v97, v97, v13
v_mul_f32 v100, v100, v10
v_mul_f32 v101, v101, v13
v_mul_f32 v104, v104, v10
v_mul_f32 v105, v105, v13
v_mul_f32 v108, v108, v10
v_mul_f32 v109, v109, v13
v_mul_f32 v112, v112, v10
v_mul_f32 v113, v113, v13
v_mul_f32 v116, v116, v10
v_mul_f32 v117, v117, v13
v_mul_f32 v120, v120, v10
v_mul_f32 v121, v121, v13
v_mul_f32 v124, v124, v10
v_mul_f32 v125, v125, v13
L_xsm:
v_and_b32 v9, 1, v1
v_lshlrev_b32 v9, 6, v9
s_lshl_b32 s70, s20, 4
v_lshl_add_u32 v21, v2, 2, v9
v_add_u32 v21, s70, v21
v_add_f32 v23, v23, v24
ds_write_b32 v21, v23 offset:4736
ds_write_b32 v21, v20 offset:4608
s_lshl_b32 s70, s20, 10
v_lshlrev_b32 v6, 9, v2
v_lshl_add_u32 v6, v1, 5, v6
v_add_u32 v6, s70, v6
s_lshl_b32 s70, s20, 8
v_lshl_add_u32 v7, v0, 3, s70
s_lshr_b32 s71, s20, 1
s_lshl_b32 s72, s71, 6
v_mov_b32 v8, s72
s_lshl_b32 s72, s20, 3
s_add_u32 s72, s72, 1024
v_mov_b32 v9, s72
v_cmp_eq_u32 s[76:77], 32, v0
s_nop 1
v_cndmask_b32 v25, v7, v9, s[76:77]
s_lshl_b32 s75, s3, 3
s_lshl_b32 s75, s75, 11
s_add_u32 s75, s75, 262144
v_and_b32 v9, 7, v1
v_lshlrev_b32 v9, 11, v9
v_lshl_add_u32 v26, v2, 5, v9
v_add_u32 v26, s70, v26
v_and_b32 v9, 1, v2
v_lshlrev_b32 v9, 2, v9
v_and_b32 v10, 3, v1
v_add_u32 v9, v9, v10
s_lshl_b32 s72, s71, 4
s_add_u32 s72, s72, 1024
v_lshl_add_u32 v27, v9, 11, s72
v_and_b32 v9, 1, v2
v_cmp_ne_u32 s[62:63], 0, v9
s_waitcnt vmcnt(0)
s_bitcmp1_b32 s56, 0
s_cbranch_scc1 L_xp0
v_perm_b32 v48, v228, v224, s66
v_perm_b32 v49, v236, v232, s66
v_perm_b32 v50, v244, v240, s66
v_perm_b32 v51, v252, v248, s66
v_perm_b32 v52, v228, v224, s67
v_perm_b32 v53, v236, v232, s67
v_perm_b32 v54, v244, v240, s67
v_perm_b32 v55, v252, v248, s67
v_perm_b32 v56, v229, v225, s66
v_perm_b32 v57, v237, v233, s66
v_perm_b32 v58, v245, v241, s66
v_perm_b32 v59, v253, v249, s66
v_perm_b32 v60, v229, v225, s67
v_perm_b32 v61, v237, v233, s67
v_perm_b32 v62, v245, v241, s67
v_perm_b32 v63, v253, v249, s67
v_mfma_f32_16x16x32_bf16 v[96:99], v[76:79], v[48:51], v[96:99]
v_mfma_f32_16x16x32_bf16 v[100:103], v[76:79], v[52:55], v[100:103]
v_perm_b32 v48, v230, v226, s66
v_perm_b32 v49, v238, v234, s66
v_perm_b32 v50, v246, v242, s66
v_perm_b32 v51, v254, v250, s66
v_perm_b32 v52, v230, v226, s67
v_perm_b32 v53, v238, v234, s67
v_perm_b32 v54, v246, v242, s67
v_perm_b32 v55, v254, v250, s67
v_mfma_f32_16x16x32_bf16 v[104:107], v[76:79], v[56:59], v[104:107]
v_mfma_f32_16x16x32_bf16 v[108:111], v[76:79], v[60:63], v[108:111]
v_perm_b32 v56, v231, v227, s66
v_perm_b32 v57, v239, v235, s66
v_perm_b32 v58, v247, v243, s66
v_perm_b32 v59, v255, v251, s66
v_perm_b32 v60, v231, v227, s67
v_perm_b32 v61, v239, v235, s67
v_perm_b32 v62, v247, v243, s67
v_perm_b32 v63, v255, v251, s67
v_mfma_f32_16x16x32_bf16 v[112:115], v[76:79], v[48:51], v[112:115]
v_mfma_f32_16x16x32_bf16 v[116:119], v[76:79], v[52:55], v[116:119]
s_nop 1
v_mfma_f32_16x16x32_bf16 v[120:123], v[76:79], v[56:59], v[120:123]
v_mfma_f32_16x16x32_bf16 v[124:127], v[76:79], v[60:63], v[124:127]
s_branch L_xp1
L_xp0:
v_perm_b32 v48, v196, v192, s66
v_perm_b32 v49, v204, v200, s66
v_perm_b32 v50, v212, v208, s66
v_perm_b32 v51, v220, v216, s66
v_perm_b32 v52, v196, v192, s67
v_perm_b32 v53, v204, v200, s67
v_perm_b32 v54, v212, v208, s67
v_perm_b32 v55, v220, v216, s67
v_perm_b32 v56, v197, v193, s66
v_perm_b32 v57, v205, v201, s66
v_perm_b32 v58, v213, v209, s66
v_perm_b32 v59, v221, v217, s66
v_perm_b32 v60, v197, v193, s67
v_perm_b32 v61, v205, v201, s67
v_perm_b32 v62, v213, v209, s67
v_perm_b32 v63, v221, v217, s67
v_mfma_f32_16x16x32_bf16 v[96:99], v[76:79], v[48:51], v[96:99]
v_mfma_f32_16x16x32_bf16 v[100:103], v[76:79], v[52:55], v[100:103]
v_perm_b32 v48, v198, v194, s66
v_perm_b32 v49, v206, v202, s66
v_perm_b32 v50, v214, v210, s66
v_perm_b32 v51, v222, v218, s66
v_perm_b32 v52, v198, v194, s67
v_perm_b32 v53, v206, v202, s67
v_perm_b32 v54, v214, v210, s67
v_perm_b32 v55, v222, v218, s67
v_mfma_f32_16x16x32_bf16 v[104:107], v[76:79], v[56:59], v[104:107]
v_mfma_f32_16x16x32_bf16 v[108:111], v[76:79], v[60:63], v[108:111]
v_perm_b32 v56, v199, v195, s66
v_perm_b32 v57, v207, v203, s66
v_perm_b32 v58, v215, v211, s66
v_perm_b32 v59, v223, v219, s66
v_perm_b32 v60, v199, v195, s67
v_perm_b32 v61, v207, v203, s67
v_perm_b32 v62, v215, v211, s67
v_perm_b32 v63, v223, v219, s67
v_mfma_f32_16x16x32_bf16 v[112:115], v[76:79], v[48:51], v[112:115]
v_mfma_f32_16x16x32_bf16 v[116:119], v[76:79], v[52:55], v[116:119]
s_nop 1
v_mfma_f32_16x16x32_bf16 v[120:123], v[76:79], v[56:59], v[120:123]
v_mfma_f32_16x16x32_bf16 v[124:127], v[76:79], v[60:63], v[124:127]
L_xp1:
s_nop 7
v_cndmask_b32 v48, v96, v97, s[62:63]
v_cndmask_b32 v49, v100, v101, s[62:63]
v_cndmask_b32 v50, v104, v105, s[62:63]
v_cndmask_b32 v51, v108, v109, s[62:63]
v_cndmask_b32 v52, v112, v113, s[62:63]
v_cndmask_b32 v53, v116, v117, s[62:63]
v_cndmask_b32 v54, v120, v121, s[62:63]
v_cndmask_b32 v55, v124, v125, s[62:63]
s_mov_b32 exec_hi, 0
ds_write_b128 v6, v[48:51] offset:5120
ds_write_b128 v6, v[52:55] offset:5136
s_mov_b64 exec, -1
s_waitcnt lgkmcnt(0)
s_barrier
ds_read_b128 v[80:83], v8 offset:4608
ds_read_b128 v[84:87], v8 offset:4624
ds_read_b128 v[88:91], v8 offset:4640
ds_read_b128 v[92:95], v8 offset:4656
ds_read_b64 v[48:49], v7 offset:5120
ds_read_b64 v[50:51], v7 offset:6144
ds_read_b64 v[52:53], v7 offset:7168
ds_read_b64 v[54:55], v7 offset:8192
ds_read_b128 v[64:67], v8 offset:4736
ds_read_b128 v[68:71], v8 offset:4752
ds_read_b128 v[72:75], v8 offset:4768
ds_read_b128 v[76:79], v8 offset:4784
s_waitcnt lgkmcnt(8)
v_max3_f32 v80, v80, v81, v82
v_max3_f32 v84, v84, v85, v86
v_max3_f32 v88, v88, v89, v90
v_max3_f32 v92, v92, v93, v94
v_max_f32 v80, v80, v83
v_max_f32 v84, v84, v87
v_max_f32 v88, v88, v91
v_max_f32 v92, v92, v95
v_max3_f32 v81, v80, v84, v88
v_max_f32 v81, v81, v92
v_mul_f32 v81, s68, v81
v_fma_f32 v80, v80, s68, -v81
v_fma_f32 v84, v84, s68, -v81
v_fma_f32 v88, v88, s68, -v81
v_fma_f32 v92, v92, s68, -v81
v_exp_f32 v80, v80
v_exp_f32 v84, v84
v_exp_f32 v88, v88
v_exp_f32 v92, v92
s_waitcnt lgkmcnt(4)
v_mul_f32 v48, v48, v80
v_mul_f32 v49, v49, v80
v_fmac_f32 v48, v50, v84
v_fmac_f32 v49, v51, v84
v_fmac_f32 v48, v52, v88
v_fmac_f32 v49, v53, v88
v_fmac_f32 v48, v54, v92
v_fmac_f32 v49, v55, v92
v_cvt_pk_bf16_f32 v48, v48, v49
v_mov_b32 v49, s23
s_waitcnt lgkmcnt(0)
v_add_f32 v64, v64, v65
v_add_f32 v66, v66, v67
v_add_f32 v68, v68, v69
v_add_f32 v70, v70, v71
v_add_f32 v72, v72, v73
v_add_f32 v74, v74, v75
v_add_f32 v76, v76, v77
v_add_f32 v78, v78, v79
v_add_f32 v64, v64, v66
v_add_f32 v68, v68, v70
v_add_f32 v72, v72, v74
v_add_f32 v76, v76, v78
v_mul_f32 v64, v64, v80
v_fmac_f32 v64, v68, v84
v_fmac_f32 v64, v72, v88
v_fmac_f32 v64, v76, v92
v_mov_b32 v66, v81
s_and_b32 s72, s20, 1
s_cmp_lg_u32 s72, 0
s_cselect_b64 s[72:73], -1, 0
v_cndmask_b32 v64, v66, v64, s[72:73]
v_cndmask_b32 v48, v48, v64, s[76:77]
s_mov_b32 s72, -1
s_mov_b32 s73, 1
s_mov_b64 exec, s[72:73]
buffer_store_dwordx2 v[48:49], v25, s[40:43], s78 offen sc1
s_mov_b64 exec, -1
s_mov_b32 s72, 0x01ff01ff
s_mov_b32 s73, s72
s_mov_b64 exec, s[72:73]
s_mov_b32 s69, 0
buffer_load_dwordx4 v[128:131], v5, s[32:35], s69 offen nt
s_mov_b32 s69, 1152
buffer_load_dwordx4 v[132:135], v5, s[32:35], s69 offen nt
s_mov_b32 s69, 2304
buffer_load_dwordx4 v[136:139], v5, s[32:35], s69 offen nt
s_mov_b32 s69, 3456
buffer_load_dwordx4 v[140:143], v5, s[32:35], s69 offen nt
s_mov_b32 s69, 4608
buffer_load_dwordx4 v[144:147], v5, s[32:35], s69 offen nt
s_mov_b32 s69, 5760
buffer_load_dwordx4 v[148:151], v5, s[32:35], s69 offen nt
s_mov_b32 s69, 6912
buffer_load_dwordx4 v[152:155], v5, s[32:35], s69 offen nt
s_mov_b32 s69, 8064
buffer_load_dwordx4 v[156:159], v5, s[32:35], s69 offen nt
s_mov_b32 s69, 36864
buffer_load_dwordx4 v[160:163], v5, s[32:35], s69 offen nt
s_mov_b32 s69, 38016
buffer_load_dwordx4 v[164:167], v5, s[32:35], s69 offen nt
s_mov_b32 s69, 39168
buffer_load_dwordx4 v[168:171], v5, s[32:35], s69 offen nt
s_mov_b32 s69, 40320
buffer_load_dwordx4 v[172:175], v5, s[32:35], s69 offen nt
s_mov_b32 s69, 41472
buffer_load_dwordx4 v[176:179], v5, s[32:35], s69 offen nt
s_mov_b32 s69, 42624
buffer_load_dwordx4 v[180:183], v5, s[32:35], s69 offen nt
s_mov_b32 s69, 43776
buffer_load_dwordx4 v[184:187], v5, s[32:35], s69 offen nt
s_mov_b32 s69, 44928
buffer_load_dwordx4 v[188:191], v5, s[32:35], s69 offen nt
s_mov_b64 exec, -1
s_mov_b32 s60, 0x00ff00ff
s_mov_b32 s61, s60
s_mov_b64 exec, s[60:61]
buffer_load_dwordx4 v[64:67], v26, s[40:43], s75 offen offset:0 sc1
buffer_load_dwordx4 v[68:71], v26, s[40:43], s75 offen offset:16 sc1
buffer_load_dwordx4 v[72:75], v26, s[40:43], s75 offen offset:128 sc1
buffer_load_dwordx4 v[76:79], v26, s[40:43], s75 offen offset:144 sc1
s_mov_b64 exec, -1
buffer_load_dwordx4 v[80:83], v27, s[40:43], s75 offen sc1
s_waitcnt vmcnt(5)
v_perm_b32 v192, v132, v128, s66
v_perm_b32 v193, v140, v136, s66
v_perm_b32 v194, v148, v144, s66
v_perm_b32 v195, v156, v152, s66
v_perm_b32 v196, v132, v128, s67
v_perm_b32 v197, v140, v136, s67
v_perm_b32 v198, v148, v144, s67
v_perm_b32 v199, v156, v152, s67
v_perm_b32 v200, v133, v129, s66
v_perm_b32 v201, v141, v137, s66
v_perm_b32 v202, v149, v145, s66
v_perm_b32 v203, v157, v153, s66
v_perm_b32 v204, v133, v129, s67
v_perm_b32 v205, v141, v137, s67
v_perm_b32 v206, v149, v145, s67
v_perm_b32 v207, v157, v153, s67
v_perm_b32 v208, v134, v130, s66
v_perm_b32 v209, v142, v138, s66
v_perm_b32 v210, v150, v146, s66
v_perm_b32 v211, v158, v154, s66
v_perm_b32 v212, v134, v130, s67
v_perm_b32 v213, v142, v138, s67
v_perm_b32 v214, v150, v146, s67
v_perm_b32 v215, v158, v154, s67
v_perm_b32 v216, v135, v131, s66
v_perm_b32 v217, v143, v139, s66
v_perm_b32 v218, v151, v147, s66
v_perm_b32 v219, v159, v155, s66
v_perm_b32 v220, v135, v131, s67
v_perm_b32 v221, v143, v139, s67
v_perm_b32 v222, v151, v147, s67
v_perm_b32 v223, v159, v155, s67
v_perm_b32 v224, v164, v160, s66
v_perm_b32 v225, v172, v168, s66
v_perm_b32 v226, v180, v176, s66
v_perm_b32 v227, v188, v184, s66
v_perm_b32 v228, v164, v160, s67
v_perm_b32 v229, v172, v168, s67
v_perm_b32 v230, v180, v176, s67
v_perm_b32 v231, v188, v184, s67
v_perm_b32 v232, v165, v161, s66
v_perm_b32 v233, v173, v169, s66
v_perm_b32 v234, v181, v177, s66
v_perm_b32 v235, v189, v185, s66
v_perm_b32 v236, v165, v161, s67
v_perm_b32 v237, v173, v169, s67
v_perm_b32 v238, v181, v177, s67
v_perm_b32 v239, v189, v185, s67
v_perm_b32 v240, v166, v162, s66
v_perm_b32 v241, v174, v170, s66
v_perm_b32 v242, v182, v178, s66
v_perm_b32 v243, v190, v186, s66
v_perm_b32 v244, v166, v162, s67
v_perm_b32 v245, v174, v170, s67
v_perm_b32 v246, v182, v178, s67
v_perm_b32 v247, v190, v186, s67
v_perm_b32 v248, v167, v163, s66
v_perm_b32 v249, v175, v171, s66
v_perm_b32 v250, v183, v179, s66
v_perm_b32 v251, v191, v187, s66
v_perm_b32 v252, v167, v163, s67
v_perm_b32 v253, v175, v171, s67
v_perm_b32 v254, v183, v179, s67
v_perm_b32 v255, v191, v187, s67
s_mul_i32 s70, s20, 576
v_mul_u32_u24 v6, 288, v2
v_lshl_add_u32 v6, v1, 5, v6
v_add_u32 v6, s70, v6
s_mul_i32 s70, s20, 36
v_add_u32 v7, s70, v0
v_lshlrev_b32 v8, 3, v7
v_lshlrev_b32 v7, 2, v7
s_lshl_b32 s70, s5, 3
s_add_u32 s70, s70, s7
s_mul_i32 s59, s70, 18432
s_add_u32 s59, s59, 786432
s_mul_i32 s58, s6, 1152
s_add_u32 s58, s58, s59
s_lshl_b32 s70, s20, 2
s_mul_i32 s71, s6, 9
s_add_u32 s70, s70, s71
v_add_u32 v28, s70, v2
v_mul_u32_u24 v29, 1152, v1
v_lshl_add_u32 v29, v28, 3, v29
v_cmp_le_u32 vcc, 72, v28
s_mul_i32 s70, s5, 576
s_mul_i32 s71, s7, 72
s_add_u32 s70, s70, s71
v_mov_b32 v9, 1080
v_cndmask_b32 v9, 0, v9, vcc
v_add3_u32 v28, v28, v9, s70
v_lshlrev_b32 v28, 1, v28
s_mov_b32 s79, 200000
L_g1chk5:
s_waitcnt vmcnt(0)
v_min3_u32 v9, v65, v67, v69
v_max3_u32 v10, v65, v67, v69
v_min3_u32 v9, v9, v71, v73
v_max3_u32 v10, v10, v71, v73
v_min3_u32 v9, v9, v75, v77
v_max3_u32 v10, v10, v75, v77
v_min_u32 v9, v9, v79
v_max_u32 v10, v10, v79
v_cmp_ne_u32 vcc, s23, v9
v_cmp_ne_u32 s[70:71], s23, v10
v_cmp_ne_u32 s[72:73], s23, v81
v_cmp_ne_u32 s[76:77], s23, v83
s_or_b64 vcc, vcc, s[70:71]
s_and_b64 vcc, vcc, s[60:61]
s_or_b64 vcc, vcc, s[72:73]
s_or_b64 vcc, vcc, s[76:77]
s_cbranch_vccz L_g1ok6
s_sub_u32 s79, s79, 1
s_cbranch_scc1 L_g1ok6
s_mov_b64 exec, s[60:61]
buffer_load_dwordx4 v[64:67], v26, s[40:43], s75 offen offset:0 sc1
buffer_load_dwordx4 v[68:71], v26, s[40:43], s75 offen offset:16 sc1
buffer_load_dwordx4 v[72:75], v26, s[40:43], s75 offen offset:128 sc1
buffer_load_dwordx4 v[76:79], v26, s[40:43], s75 offen offset:144 sc1
s_mov_b64 exec, -1
buffer_load_dwordx4 v[80:83], v27, s[40:43], s75 offen sc1
s_branch L_g1chk5
L_g1ok6:
v_mov_b32 v65, v66
v_mov_b32 v66, v68
v_mov_b32 v67, v70
v_mov_b32 v73, v74
v_mov_b32 v74, v76
v_mov_b32 v75, v78
v_max_f32_dpp v84, v80, v80 quad_perm:[1,0,3,2] row_mask:0xf bank_mask:0xf
s_nop 1
v_mfma_f32_16x16x32_bf16 v[96:99], v[64:67], v[192:195], 0
v_max_f32_dpp v84, v84, v84 quad_perm:[2,3,0,1] row_mask:0xf bank_mask:0xf
v_mfma_f32_16x16x32_bf16 v[100:103], v[64:67], v[196:199], 0
v_sub_f32 v85, v80, v84
v_mfma_f32_16x16x32_bf16 v[104:107], v[64:67], v[200:203], 0
v_exp_f32 v85, v85
v_mfma_f32_16x16x32_bf16 v[108:111], v[64:67], v[204:207], 0
v_mul_f32 v86, v82, v85
v_mfma_f32_16x16x32_bf16 v[112:115], v[64:67], v[208:211], 0
v_mfma_f32_16x16x32_bf16 v[116:119], v[64:67], v[212:215], 0
v_add_f32_dpp v87, v86, v86 quad_perm:[1,0,3,2] row_mask:0xf bank_mask:0xf
v_mfma_f32_16x16x32_bf16 v[120:123], v[64:67], v[216:219], 0
v_mfma_f32_16x16x32_bf16 v[124:127], v[64:67], v[220:223], 0
v_add_f32_dpp v87, v87, v87 quad_perm:[2,3,0,1] row_mask:0xf bank_mask:0xf
v_mfma_f32_16x16x32_bf16 v[96:99], v[72:75], v[224:227], v[96:99]
v_rcp_f32 v87, v87
v_mfma_f32_16x16x32_bf16 v[100:103], v[72:75], v[228:231], v[100:103]
v_mul_f32 v85, v85, v87
v_mfma_f32_16x16x32_bf16 v[104:107], v[72:75], v[232:235], v[104:107]
v_mfma_f32_16x16x32_bf16 v[108:111], v[72:75], v[236:239], v[108:111]
v_mfma_f32_16x16x32_bf16 v[112:115], v[72:75], v[240:243], v[112:115]
v_mov_b32_dpp v88, v85 quad_perm:[0,0,0,0] row_mask:0xf bank_mask:0xf
v_mfma_f32_16x16x32_bf16 v[116:119], v[72:75], v[244:247], v[116:119]
v_mov_b32_dpp v89, v85 quad_perm:[1,1,1,1] row_mask:0xf bank_mask:0xf
v_mfma_f32_16x16x32_bf16 v[120:123], v[72:75], v[248:251], v[120:123]
v_mov_b32_dpp v90, v85 quad_perm:[2,2,2,2] row_mask:0xf bank_mask:0xf
v_mfma_f32_16x16x32_bf16 v[124:127], v[72:75], v[252:255], v[124:127]
v_mov_b32_dpp v91, v85 quad_perm:[3,3,3,3] row_mask:0xf bank_mask:0xf
s_nop 3
v_mul_f32 v48, v96, v88
v_mul_f32 v49, v100, v88
v_mul_f32 v50, v104, v88
v_mul_f32 v51, v108, v88
v_mul_f32 v52, v112, v88
v_mul_f32 v53, v116, v88
v_mul_f32 v54, v120, v88
v_mul_f32 v55, v124, v88
v_fmac_f32 v48, v97, v89
v_fmac_f32 v49, v101, v89
v_fmac_f32 v50, v105, v89
v_fmac_f32 v51, v109, v89
v_fmac_f32 v52, v113, v89
v_fmac_f32 v53, v117, v89
v_fmac_f32 v54, v121, v89
v_fmac_f32 v55, v125, v89
v_fmac_f32 v48, v98, v90
v_fmac_f32 v49, v102, v90
v_fmac_f32 v50, v106, v90
v_fmac_f32 v51, v110, v90
v_fmac_f32 v52, v114, v90
v_fmac_f32 v53, v118, v90
v_fmac_f32 v54, v122, v90
v_fmac_f32 v55, v126, v90
v_fmac_f32 v48, v99, v91
v_fmac_f32 v49, v103, v91
v_fmac_f32 v50, v107, v91
v_fmac_f32 v51, v111, v91
v_fmac_f32 v52, v115, v91
v_fmac_f32 v53, v119, v91
v_fmac_f32 v54, v123, v91
v_fmac_f32 v55, v127, v91
s_mov_b64 exec, 0x01ff01ff
ds_write_b128 v6, v[48:51] offset:9216
ds_write_b128 v6, v[52:55] offset:9232
s_mov_b64 exec, -1
s_waitcnt lgkmcnt(0)
s_barrier
ds_read_b32 v48, v7 offset:9216
ds_read_b32 v49, v7 offset:9792
ds_read_b32 v50, v7 offset:10368
ds_read_b32 v51, v7 offset:10944
v_mov_b32 v53, s23
s_mov_b32 s72, -1
s_mov_b32 s73, 15
s_waitcnt lgkmcnt(0)
v_add_f32 v48, v48, v49
v_add_f32 v50, v50, v51
v_add_f32 v52, v48, v50
s_mov_b64 exec, s[72:73]
buffer_store_dwordx2 v[52:53], v8, s[40:43], s58 offen sc1
s_mov_b64 exec, -1
s_cmp_eq_u32 s20, 3
s_cbranch_scc1 L_fin
s_cmp_eq_u32 s20, 2
s_cselect_b32 s72, 0xffff, -1
s_cselect_b32 s73, 0, -1
s_mov_b64 exec, s[72:73]
s_mov_b32 s79, 200000
L_g2chk7:
buffer_load_dwordx2 v[56:57], v29, s[40:43], s59 offen sc1
s_waitcnt vmcnt(0)
v_cmp_ne_u32 vcc, s23, v57
s_cbranch_vccz L_g2ok8
s_sub_u32 s79, s79, 1
s_cbranch_scc0 L_g2chk7
L_g2ok8:
s_nop 1
v_add_f32_dpp v56, v56, v56 row_ror:8 row_mask:0xf bank_mask:0xf
s_nop 1
v_add_f32_dpp v56, v56, v56 row_ror:4 row_mask:0xf bank_mask:0xf
s_nop 1
v_add_f32_dpp v56, v56, v56 row_ror:2 row_mask:0xf bank_mask:0xf
s_nop 1
v_add_f32_dpp v56, v56, v56 row_ror:1 row_mask:0xf bank_mask:0xf
v_cmp_eq_u32 vcc, 0, v1
v_cvt_pk_bf16_f32 v56, v56, v56
s_and_b64 exec, exec, vcc
buffer_store_short v56, v28, s[44:47], 0 offen
s_or_b32 s70, s6, s4
s_or_b32 s70, s70, s20
s_cmp_lg_u32 s70, 0
s_cbranch_scc1 L_fin
s_mov_b64 exec, 1
s_lshl_b32 s70, s5, 8
s_add_u32 s70, s70, 1114112
v_mov_b32 v9, 0
buffer_store_dword v53, v9, s[40:43], s70 offen
L_fin:
L_end:
s_endpgm
.section .rodata,"a"
.p2align 6
.amdhsa_kernel concat_heads__sliding_block_cached__sliding_block_cached__decode_kernel
  .amdhsa_next_free_vgpr 512
  .amdhsa_next_free_sgpr 102
  .amdhsa_accum_offset 256
  .amdhsa_group_segment_fixed_size 0
  .amdhsa_kernarg_size 104
  .amdhsa_user_sgpr_count 2
  .amdhsa_user_sgpr_kernarg_segment_ptr 1
  .amdhsa_system_sgpr_workgroup_id_x 1
.end_amdhsa_kernel
```
